```python
import torch

def _softmax(x, axis=-1):
    return torch.softmax(x, dim=axis)
def _gelu(x):
    return torch.nn.functional.gelu(x, approximate="tanh")
def _silu(x):
    return torch.nn.functional.silu(x)
def _sigmoid(x):
    return torch.sigmoid(x)
def _layernorm(x, axis=-1, eps=1e-5):
    m = x.mean(dim=axis, keepdim=True)
    v = x.var(dim=axis, keepdim=True, unbiased=False)
    return (x - m) / torch.sqrt(v + eps)
def _scatter_add(tgt, idx, src, axis=0):
    return tgt.clone().index_add_(axis, idx, src)
def _segment_sum(src, seg, n):
    out = torch.zeros((n,) + src.shape[1:], dtype=src.dtype)
    return out.index_add_(0, seg, src)
def _pad(x, pw):
    flat = tuple(v for pair in reversed(pw) for v in pair)
    return torch.nn.functional.pad(x, flat)

kernel_name = 'standalone__low_rank_proj_linformer__decode'

def setup_inputs():

    _w = (lambda a: (lambda t: t.to(torch.bfloat16) if t.is_floating_point() else t)(torch.as_tensor(a)))
    B, H, Sq, Skv, Dh, R = 2, 32, 1, 8192, 128, 16
    return {
        "q": _w((lambda *s: torch.randn(*s, dtype=torch.bfloat16) * 0.8)(B, H, Sq, Dh)),
        "k": _w((lambda *s: torch.randn(*s, dtype=torch.bfloat16) * 0.8)(B, H, Skv, Dh)),
        "v": _w((lambda *s: torch.randn(*s, dtype=torch.bfloat16) * 0.05)(B, H, Skv, Dh)),
        "e_proj": _w((lambda *s: torch.randn(*s, dtype=torch.bfloat16) * 0.8)(R, Skv) * (Skv ** -0.5)),
        "f_proj": _w((lambda *s: torch.randn(*s, dtype=torch.bfloat16) * 0.05)(R, Skv) * (Skv ** -0.5)),
    }

def reference(q, k, v, e_proj, f_proj):
    B, H, Sq, Dh = q.shape
    kp = torch.einsum("rn,bhnd->bhrd", e_proj, k)
    vp = torch.einsum("rn,bhnd->bhrd", f_proj, v)
    scores = torch.einsum("bhqd,bhrd->bhqr", q, kp) * (Dh ** -0.5)
    p = _softmax(scores, axis=-1)
    o = torch.einsum("bhqr,bhrd->bhqd", p, vp)
    return o
```

```asm
; @launch grid=(256,1,1) block=(256,1,1) lds=83968
.amdgcn_target "amdgcn-amd-amdhsa--gfx950"
.text
.globl standalone__low_rank_proj_linformer__decode_kernel
.p2align 8
.type standalone__low_rank_proj_linformer__decode_kernel,@function
standalone__low_rank_proj_linformer__decode_kernel:
    s_cmp_ge_u32 s2, 256
    s_cbranch_scc1 L_end
    s_load_dwordx16 s[4:19], s[0:1], 0
    v_lshrrev_b32 v1, 6, v0
    v_and_b32 v3, 63, v0
    v_readfirstlane_b32 s20, v1
    v_lshrrev_b32 v4, 4, v3
    v_and_b32 v5, 15, v3
    v_lshlrev_b32 v1, 12, v4
    v_lshl_add_u32 v1, v5, 4, v1
    v_lshlrev_b32 v2, 14, v5
    v_lshl_add_u32 v2, v4, 5, v2
    s_and_b32 s21, s2, 3
    s_lshr_b32 s54, s2, 2
    s_lshl_b32 s22, s21, 2
    s_add_u32 s60, s22, s20
    s_lshl_b32 s50, s60, 14
    s_lshl_b32 s51, s60, 7
    s_lshl_b32 s23, s54, 21
    s_mov_b32 s26, 0x200000
    s_mov_b32 s27, 0x20000
    s_mov_b32 s30, 0x40000
    s_mov_b32 s31, 0x20000
    s_waitcnt lgkmcnt(0)
    s_add_u32 s24, s6, s23
    s_addc_u32 s25, s7, 0
    s_mov_b32 s28, s10
    s_mov_b32 s29, s11
    buffer_load_dwordx4 v[60:63], v1, s[24:27], s50 offen offset:0 nt
    buffer_load_dwordx4 v[64:67], v1, s[24:27], s50 offen offset:256 nt
    buffer_load_dwordx4 v[68:71], v1, s[24:27], s50 offen offset:512 nt
    buffer_load_dwordx4 v[72:75], v1, s[24:27], s50 offen offset:768 nt
    buffer_load_dwordx4 v[76:79], v1, s[24:27], s50 offen offset:1024 nt
    buffer_load_dwordx4 v[80:83], v1, s[24:27], s50 offen offset:1280 nt
    buffer_load_dwordx4 v[84:87], v1, s[24:27], s50 offen offset:1536 nt
    buffer_load_dwordx4 v[88:91], v1, s[24:27], s50 offen offset:1792 nt
    buffer_load_dwordx4 v[48:51], v2, s[28:31], s51 offen
    buffer_load_dwordx4 v[52:55], v2, s[28:31], s51 offen offset:16
    buffer_load_dwordx4 v[92:95], v1, s[24:27], s50 offen offset:2048 nt
    buffer_load_dwordx4 v[96:99], v1, s[24:27], s50 offen offset:2304 nt
    buffer_load_dwordx4 v[100:103], v1, s[24:27], s50 offen offset:2560 nt
    buffer_load_dwordx4 v[104:107], v1, s[24:27], s50 offen offset:2816 nt
    buffer_load_dwordx4 v[108:111], v1, s[24:27], s50 offen offset:3072 nt
    buffer_load_dwordx4 v[112:115], v1, s[24:27], s50 offen offset:3328 nt
    buffer_load_dwordx4 v[116:119], v1, s[24:27], s50 offen offset:3584 nt
    buffer_load_dwordx4 v[120:123], v1, s[24:27], s50 offen offset:3840 nt
    s_lshl_b32 s55, s54, 8
    s_add_u32 s32, s4, s55
    s_addc_u32 s33, s5, 0
    s_mov_b32 s34, 256
    s_mov_b32 s35, 0x20000
    v_lshlrev_b32 v6, 4, v5
    buffer_load_dwordx4 v[4:7], v6, s[32:35], 0 offen
    s_lshr_b32 s22, s2, 3
    s_lshl_b32 s22, s22, 2
    s_add_u32 s22, s22, s20
    s_lshr_b32 s53, s22, 2
    s_lshl_b32 s53, s53, 4
    s_and_b32 s36, s22, 3
    s_add_u32 s53, s53, s36
    s_lshl_b32 s36, s21, 2
    s_add_u32 s53, s53, s36
    s_add_u32 s36, s22, 156
    s_cmp_lt_u32 s22, 52
    s_cselect_b32 s53, s53, s36
    s_min_u32 s53, s53, 255
    s_cmp_lt_u32 s53, 128
    s_cselect_b32 s36, s10, s12
    s_cselect_b32 s37, s11, s13
    s_mov_b32 s38, 0x40000
    s_mov_b32 s39, 0x20000
    s_and_b32 s53, s53, 127
    s_lshl_b32 s53, s53, 7
    buffer_load_dword v135, v2, s[36:39], s53 offen
    s_mul_i32 s22, s54, 8192
    s_add_u32 s64, s18, s22
    s_addc_u32 s65, s19, 0
    s_mov_b32 s66, 8192
    s_mov_b32 s67, 0x20000
    v_mov_b32 v124, 0
    v_mov_b32 v125, 0
    v_mov_b32 v126, 0
    s_mov_b32 s71, s60
    s_cmp_lg_u32 s60, 0
    s_cbranch_scc1 L_noinit
    v_lshlrev_b32 v133, 4, v3
    v_mov_b32 v136, 0
    v_mov_b32 v140, -1
    v_mov_b32 v137, 0
    v_mov_b32 v141, -1
    v_mov_b32 v138, 0
    v_mov_b32 v142, -1
    v_mov_b32 v139, 0
    v_mov_b32 v143, -1
    buffer_store_dwordx4 v[136:139], v133, s[64:67], 0 offen sc1
    buffer_store_dwordx4 v[140:143], v133, s[64:67], 0 offen offset:1024 sc1
    buffer_store_dwordx4 v[140:143], v133, s[64:67], 0 offen offset:2048 sc1
    buffer_store_dwordx4 v[140:143], v133, s[64:67], 0 offen offset:3072 sc1
L_noinit:
    v_mov_b32 v8, 0
    v_mov_b32 v9, 0
    v_mov_b32 v10, 0
    v_mov_b32 v11, 0
    v_mov_b32 v12, 0
    v_mov_b32 v13, 0
    v_mov_b32 v14, 0
    v_mov_b32 v15, 0
    v_mov_b32 v16, 0
    v_mov_b32 v17, 0
    v_mov_b32 v18, 0
    v_mov_b32 v19, 0
    v_mov_b32 v20, 0
    v_mov_b32 v21, 0
    v_mov_b32 v22, 0
    v_mov_b32 v23, 0
    v_mov_b32 v24, 0
    v_mov_b32 v25, 0
    v_mov_b32 v26, 0
    v_mov_b32 v27, 0
    v_mov_b32 v28, 0
    v_mov_b32 v29, 0
    v_mov_b32 v30, 0
    v_mov_b32 v31, 0
    v_mov_b32 v32, 0
    v_mov_b32 v33, 0
    v_mov_b32 v34, 0
    v_mov_b32 v35, 0
    v_mov_b32 v36, 0
    v_mov_b32 v37, 0
    v_mov_b32 v38, 0
    v_mov_b32 v39, 0
    s_add_u32 s58, s8, s23
    s_addc_u32 s59, s9, 0
    s_mov_b32 s56, s24
    s_mov_b32 s57, s25
    s_add_u32 s40, s14, s55
    s_addc_u32 s41, s15, 0
    s_mov_b32 s42, 256
    s_mov_b32 s43, 0x20000
    s_mov_b32 s44, s16
    s_mov_b32 s45, s17
    s_mov_b32 s46, 256
    s_mov_b32 s47, 0x20000
    s_lshl_b32 s22, s54, 2
    v_mov_b32 v127, s22
    s_mov_b32 s48, 0x05040100
    s_mov_b32 s49, 0x07060302
    v_lshrrev_b32 v132, 4, v3
    v_lshlrev_b32 v132, 4, v132
    v_and_b32 v133, 15, v3
    v_lshl_add_u32 v132, v133, 6, v132
    v_add_u32 v132, 1024, v132
    s_mov_b32 s61, 0
    s_mov_b32 s62, 0
    s_mov_b32 s63, 0
    s_mov_b32 s68, 0
    s_mov_b32 s72, 0
    s_mov_b32 s74, 0
    s_add_u32 s60, s60, 16
    s_branch L_first
L_loop:
    s_waitcnt vmcnt(8)
L_s0:
    s_mov_b32 s75, 0
L_s0b:
    s_cmp_eq_u32 s68, 0
    s_cbranch_scc1 L_stat
    v_readfirstlane_b32 s60, v124
    s_add_u32 s60, s60, 208
L_stat:
    s_cmp_eq_u32 s72, 1
    s_cbranch_scc1 L_pchk
L_pret:
    s_cmp_lg_u32 s62, s61
    s_cbranch_scc1 L_flushk
L_flushret:
    v_perm_b32 v40, v64, v60, s48
    v_perm_b32 v41, v72, v68, s48
    v_perm_b32 v42, v80, v76, s48
    v_perm_b32 v43, v88, v84, s48
    v_perm_b32 v44, v64, v60, s49
    v_perm_b32 v45, v72, v68, s49
    v_perm_b32 v46, v80, v76, s49
    v_perm_b32 v47, v88, v84, s49
    v_mfma_f32_16x16x32_bf16 v[8:11], v[48:51], v[40:43], v[8:11]
    v_perm_b32 v40, v65, v61, s48
    v_perm_b32 v41, v73, v69, s48
    v_perm_b32 v42, v81, v77, s48
    v_perm_b32 v43, v89, v85, s48
    v_mfma_f32_16x16x32_bf16 v[12:15], v[48:51], v[44:47], v[12:15]
    v_perm_b32 v44, v65, v61, s49
    v_perm_b32 v45, v73, v69, s49
    v_perm_b32 v46, v81, v77, s49
    v_perm_b32 v47, v89, v85, s49
    v_mfma_f32_16x16x32_bf16 v[16:19], v[48:51], v[40:43], v[16:19]
    v_perm_b32 v40, v66, v62, s48
    v_perm_b32 v41, v74, v70, s48
    v_perm_b32 v42, v82, v78, s48
    v_perm_b32 v43, v90, v86, s48
    v_mfma_f32_16x16x32_bf16 v[20:23], v[48:51], v[44:47], v[20:23]
    v_perm_b32 v44, v66, v62, s49
    v_perm_b32 v45, v74, v70, s49
    v_perm_b32 v46, v82, v78, s49
    v_perm_b32 v47, v90, v86, s49
    v_mfma_f32_16x16x32_bf16 v[24:27], v[48:51], v[40:43], v[24:27]
    v_perm_b32 v40, v67, v63, s48
    v_perm_b32 v41, v75, v71, s48
    v_perm_b32 v42, v83, v79, s48
    v_perm_b32 v43, v91, v87, s48
    v_mfma_f32_16x16x32_bf16 v[28:31], v[48:51], v[44:47], v[28:31]
    v_perm_b32 v44, v67, v63, s49
    v_perm_b32 v45, v75, v71, s49
    v_perm_b32 v46, v83, v79, s49
    v_perm_b32 v47, v91, v87, s49
    v_mfma_f32_16x16x32_bf16 v[32:35], v[48:51], v[40:43], v[32:35]
    s_nop 0
    v_mfma_f32_16x16x32_bf16 v[36:39], v[48:51], v[44:47], v[36:39]
    v_mov_b32 v56, v52
    v_mov_b32 v57, v53
    v_mov_b32 v58, v54
    v_mov_b32 v59, v55
    s_cmp_ge_u32 s60, 256
    s_cbranch_scc1 L_skip0
    s_add_u32 s70, s60, 16
    s_cmp_lt_u32 s70, 208
    s_cselect_b32 s73, 0, 1
    s_cbranch_scc1 L_noat0
    v_mov_b32 v134, 1
    s_mov_b64 exec, 1
    buffer_atomic_add v134, v125, s[64:67], 0 offen sc0
    s_mov_b64 exec, -1
    s_mov_b32 s75, 1
L_noat0:
    s_lshr_b32 s69, s60, 7
    s_and_b32 s22, s60, 127
    s_lshl_b32 s50, s22, 14
    s_lshl_b32 s51, s22, 7
    s_cmp_eq_u32 s69, 0
    s_cselect_b32 s24, s56, s58
    s_cselect_b32 s25, s57, s59
    s_cselect_b32 s28, s10, s12
    s_cselect_b32 s29, s11, s13
    buffer_load_dwordx4 v[48:51], v2, s[28:31], s51 offen
    buffer_load_dwordx4 v[52:55], v2, s[28:31], s51 offen offset:16
    buffer_load_dwordx4 v[60:63], v1, s[24:27], s50 offen offset:0 nt
    buffer_load_dwordx4 v[64:67], v1, s[24:27], s50 offen offset:256 nt
    buffer_load_dwordx4 v[68:71], v1, s[24:27], s50 offen offset:512 nt
    buffer_load_dwordx4 v[72:75], v1, s[24:27], s50 offen offset:768 nt
    buffer_load_dwordx4 v[76:79], v1, s[24:27], s50 offen offset:1024 nt
    buffer_load_dwordx4 v[80:83], v1, s[24:27], s50 offen offset:1280 nt
    buffer_load_dwordx4 v[84:87], v1, s[24:27], s50 offen offset:1536 nt
    buffer_load_dwordx4 v[88:91], v1, s[24:27], s50 offen offset:1792 nt
    s_cmp_eq_u32 s75, 0
    s_cbranch_scc1 L_w10
    s_cmp_eq_u32 s75, 1
    s_cbranch_scc1 L_w11
    s_waitcnt vmcnt(12)
    s_branch L_go1
L_w11:
    s_waitcnt vmcnt(11)
    s_branch L_go1
L_w10:
    s_waitcnt vmcnt(10)
    s_branch L_go1
L_skip0:
    s_waitcnt vmcnt(0)
L_go1:
    v_perm_b32 v40, v96, v92, s48
    v_perm_b32 v41, v104, v100, s48
    v_perm_b32 v42, v112, v108, s48
    v_perm_b32 v43, v120, v116, s48
    v_perm_b32 v44, v96, v92, s49
    v_perm_b32 v45, v104, v100, s49
    v_perm_b32 v46, v112, v108, s49
    v_perm_b32 v47, v120, v116, s49
    v_mfma_f32_16x16x32_bf16 v[8:11], v[56:59], v[40:43], v[8:11]
    v_perm_b32 v40, v97, v93, s48
    v_perm_b32 v41, v105, v101, s48
    v_perm_b32 v42, v113, v109, s48
    v_perm_b32 v43, v121, v117, s48
    v_mfma_f32_16x16x32_bf16 v[12:15], v[56:59], v[44:47], v[12:15]
    v_perm_b32 v44, v97, v93, s49
    v_perm_b32 v45, v105, v101, s49
    v_perm_b32 v46, v113, v109, s49
    v_perm_b32 v47, v121, v117, s49
    v_mfma_f32_16x16x32_bf16 v[16:19], v[56:59], v[40:43], v[16:19]
    v_perm_b32 v40, v98, v94, s48
    v_perm_b32 v41, v106, v102, s48
    v_perm_b32 v42, v114, v110, s48
    v_perm_b32 v43, v122, v118, s48
    v_mfma_f32_16x16x32_bf16 v[20:23], v[56:59], v[44:47], v[20:23]
    v_perm_b32 v44, v98, v94, s49
    v_perm_b32 v45, v106, v102, s49
    v_perm_b32 v46, v114, v110, s49
    v_perm_b32 v47, v122, v118, s49
    v_mfma_f32_16x16x32_bf16 v[24:27], v[56:59], v[40:43], v[24:27]
    v_perm_b32 v40, v99, v95, s48
    v_perm_b32 v41, v107, v103, s48
    v_perm_b32 v42, v115, v111, s48
    v_perm_b32 v43, v123, v119, s48
    v_mfma_f32_16x16x32_bf16 v[28:31], v[56:59], v[44:47], v[28:31]
    v_perm_b32 v44, v99, v95, s49
    v_perm_b32 v45, v107, v103, s49
    v_perm_b32 v46, v115, v111, s49
    v_perm_b32 v47, v123, v119, s49
    v_mfma_f32_16x16x32_bf16 v[32:35], v[56:59], v[40:43], v[32:35]
    s_nop 0
    v_mfma_f32_16x16x32_bf16 v[36:39], v[56:59], v[44:47], v[36:39]
    s_cmp_ge_u32 s60, 256
    s_cbranch_scc1 L_exit
    s_mov_b32 s62, s69
    s_add_u32 s63, s63, 1
    s_cmp_le_u32 s63, 4
    s_cbranch_scc1 L_early
L_earlyret:
    s_cmp_lt_u32 s63, 10
    s_cbranch_scc1 L_nopld
    s_cmp_lg_u32 s72, 0
    s_cbranch_scc1 L_nopld
    buffer_load_dwordx4 v[128:131], v132, s[64:67], 0 offen sc1
    s_mov_b32 s72, 1
L_nopld:
    buffer_load_dwordx4 v[92:95], v1, s[24:27], s50 offen offset:2048 nt
    buffer_load_dwordx4 v[96:99], v1, s[24:27], s50 offen offset:2304 nt
    buffer_load_dwordx4 v[100:103], v1, s[24:27], s50 offen offset:2560 nt
    buffer_load_dwordx4 v[104:107], v1, s[24:27], s50 offen offset:2816 nt
    buffer_load_dwordx4 v[108:111], v1, s[24:27], s50 offen offset:3072 nt
    buffer_load_dwordx4 v[112:115], v1, s[24:27], s50 offen offset:3328 nt
    buffer_load_dwordx4 v[116:119], v1, s[24:27], s50 offen offset:3584 nt
    buffer_load_dwordx4 v[120:123], v1, s[24:27], s50 offen offset:3840 nt
    s_mov_b32 s60, s70
    s_mov_b32 s68, s73
    s_cmp_eq_u32 s73, 0
    s_cbranch_scc1 L_loop
    s_waitcnt vmcnt(8)
    v_mov_b32 v124, v134
    s_nop 0
    s_branch L_s0
L_first:
    s_cmp_lg_u32 s71, 0
    s_cbranch_scc1 L_first1
    s_waitcnt vmcnt(0)
    v_mov_b32 v126, 0x10000
    s_mov_b64 exec, 1
    buffer_atomic_add v126, v127, s[44:47], 0 offen
    s_mov_b64 exec, -1
    s_branch L_s0
L_first1:
    s_waitcnt vmcnt(10)
    s_mov_b32 s75, 2
    s_branch L_s0b
L_early:
    s_cmp_lg_u32 s63, 4
    s_cbranch_scc1 L_earlyret
    buffer_load_dword v126, v127, s[44:47], 0 offen sc1
    s_branch L_earlyret
L_pchk:
L_pchk_x:
    v_max_u32 v136, v128, v129
    v_max3_u32 v136, v130, v131, v136
    v_cmp_eq_u32 vcc, -1, v136
    s_nop 4
    s_cbranch_vccnz L_pbad
    s_nop 0
    v_add_f32_dpp v128, v128, v128 row_ror:8 row_mask:0xf bank_mask:0xf
    v_add_f32_dpp v129, v129, v129 row_ror:8 row_mask:0xf bank_mask:0xf
    v_add_f32_dpp v130, v130, v130 row_ror:8 row_mask:0xf bank_mask:0xf
    v_add_f32_dpp v131, v131, v131 row_ror:8 row_mask:0xf bank_mask:0xf
    s_nop 0
    v_add_f32_dpp v128, v128, v128 row_ror:4 row_mask:0xf bank_mask:0xf
    v_add_f32_dpp v129, v129, v129 row_ror:4 row_mask:0xf bank_mask:0xf
    v_add_f32_dpp v130, v130, v130 row_ror:4 row_mask:0xf bank_mask:0xf
    v_add_f32_dpp v131, v131, v131 row_ror:4 row_mask:0xf bank_mask:0xf
    s_nop 0
    v_add_f32_dpp v128, v128, v128 row_ror:2 row_mask:0xf bank_mask:0xf
    v_add_f32_dpp v129, v129, v129 row_ror:2 row_mask:0xf bank_mask:0xf
    v_add_f32_dpp v130, v130, v130 row_ror:2 row_mask:0xf bank_mask:0xf
    v_add_f32_dpp v131, v131, v131 row_ror:2 row_mask:0xf bank_mask:0xf
    s_nop 0
    v_add_f32_dpp v128, v128, v128 row_ror:1 row_mask:0xf bank_mask:0xf
    v_add_f32_dpp v129, v129, v129 row_ror:1 row_mask:0xf bank_mask:0xf
    v_add_f32_dpp v130, v130, v130 row_ror:1 row_mask:0xf bank_mask:0xf
    v_add_f32_dpp v131, v131, v131 row_ror:1 row_mask:0xf bank_mask:0xf
    v_max_f32 v136, v128, v129
    v_max3_f32 v136, v130, v131, v136
    v_mov_b32 v137, v136
    s_nop 1
    v_permlane16_swap_b32 v136, v137
    s_nop 1
    v_max_f32 v136, v136, v137
    v_mov_b32 v137, v136
    s_nop 1
    v_permlane32_swap_b32 v136, v137
    s_nop 1
    v_max_f32 v136, v136, v137
    s_mov_b32 s22, 0x3e0293ee
    v_sub_f32 v128, v128, v136
    v_sub_f32 v129, v129, v136
    v_sub_f32 v130, v130, v136
    v_sub_f32 v131, v131, v136
    v_mul_f32 v128, s22, v128
    v_mul_f32 v129, s22, v129
    v_mul_f32 v130, s22, v130
    v_mul_f32 v131, s22, v131
    v_exp_f32 v128, v128
    v_exp_f32 v129, v129
    v_exp_f32 v130, v130
    v_exp_f32 v131, v131
    s_nop 0
    v_add_f32 v136, v128, v129
    v_add_f32 v137, v130, v131
    v_add_f32 v136, v136, v137
    v_mov_b32 v137, v136
    s_nop 1
    v_permlane16_swap_b32 v136, v137
    s_nop 1
    v_add_f32 v136, v136, v137
    v_mov_b32 v137, v136
    s_nop 1
    v_permlane32_swap_b32 v136, v137
    s_nop 1
    v_add_f32 v136, v136, v137
    v_rcp_f32 v136, v136
    s_nop 0
    v_mul_f32 v128, v128, v136
    v_mul_f32 v129, v129, v136
    v_mul_f32 v130, v130, v136
    v_mul_f32 v131, v131, v136
    s_mov_b32 s72, 2
    s_branch L_pdone
L_pbad:
    s_mov_b32 s72, 0
L_pdone:
    s_cmp_eq_u32 s74, 1
    s_cbranch_scc1 L_exitp
    s_branch L_pret
L_flushk:
    s_nop 7
    v_lshlrev_b32 v40, 16, v4
    v_and_b32 v41, 0xffff0000, v4
    v_mul_f32 v44, v40, v8
    v_mul_f32 v45, v40, v9
    v_mul_f32 v46, v40, v10
    v_mul_f32 v47, v40, v11
    v_fmac_f32 v44, v41, v12
    v_fmac_f32 v45, v41, v13
    v_fmac_f32 v46, v41, v14
    v_fmac_f32 v47, v41, v15
    v_lshlrev_b32 v40, 16, v5
    v_and_b32 v41, 0xffff0000, v5
    v_fmac_f32 v44, v40, v16
    v_fmac_f32 v45, v40, v17
    v_fmac_f32 v46, v40, v18
    v_fmac_f32 v47, v40, v19
    v_fmac_f32 v44, v41, v20
    v_fmac_f32 v45, v41, v21
    v_fmac_f32 v46, v41, v22
    v_fmac_f32 v47, v41, v23
    v_lshlrev_b32 v40, 16, v6
    v_and_b32 v41, 0xffff0000, v6
    v_fmac_f32 v44, v40, v24
    v_fmac_f32 v45, v40, v25
    v_fmac_f32 v46, v40, v26
    v_fmac_f32 v47, v40, v27
    v_fmac_f32 v44, v41, v28
    v_fmac_f32 v45, v41, v29
    v_fmac_f32 v46, v41, v30
    v_fmac_f32 v47, v41, v31
    v_lshlrev_b32 v40, 16, v7
    v_and_b32 v41, 0xffff0000, v7
    v_fmac_f32 v44, v40, v32
    v_fmac_f32 v45, v40, v33
    v_fmac_f32 v46, v40, v34
    v_fmac_f32 v47, v40, v35
    v_fmac_f32 v44, v41, v36
    v_fmac_f32 v45, v41, v37
    v_fmac_f32 v46, v41, v38
    v_fmac_f32 v47, v41, v39
    s_nop 0
    v_add_f32_dpp v44, v44, v44 row_ror:8 row_mask:0xf bank_mask:0xf
    v_add_f32_dpp v45, v45, v45 row_ror:8 row_mask:0xf bank_mask:0xf
    v_add_f32_dpp v46, v46, v46 row_ror:8 row_mask:0xf bank_mask:0xf
    v_add_f32_dpp v47, v47, v47 row_ror:8 row_mask:0xf bank_mask:0xf
    s_nop 0
    v_add_f32_dpp v44, v44, v44 row_ror:4 row_mask:0xf bank_mask:0xf
    v_add_f32_dpp v45, v45, v45 row_ror:4 row_mask:0xf bank_mask:0xf
    v_add_f32_dpp v46, v46, v46 row_ror:4 row_mask:0xf bank_mask:0xf
    v_add_f32_dpp v47, v47, v47 row_ror:4 row_mask:0xf bank_mask:0xf
    s_nop 0
    v_add_f32_dpp v44, v44, v44 row_ror:2 row_mask:0xf bank_mask:0xf
    v_add_f32_dpp v45, v45, v45 row_ror:2 row_mask:0xf bank_mask:0xf
    v_add_f32_dpp v46, v46, v46 row_ror:2 row_mask:0xf bank_mask:0xf
    v_add_f32_dpp v47, v47, v47 row_ror:2 row_mask:0xf bank_mask:0xf
    s_nop 0
    v_add_f32_dpp v44, v44, v44 row_ror:1 row_mask:0xf bank_mask:0xf
    v_add_f32_dpp v45, v45, v45 row_ror:1 row_mask:0xf bank_mask:0xf
    v_add_f32_dpp v46, v46, v46 row_ror:1 row_mask:0xf bank_mask:0xf
    v_add_f32_dpp v47, v47, v47 row_ror:1 row_mask:0xf bank_mask:0xf
    s_mov_b32 s22, 0xfffffffe
    v_min_u32 v44, s22, v44
    v_min_u32 v45, s22, v45
    v_min_u32 v46, s22, v46
    v_min_u32 v47, s22, v47
L_flagwait:
    s_cmp_eq_u32 s71, 0
    s_cbranch_scc1 L_flagok
    v_readfirstlane_b32 s22, v126
    s_lshr_b32 s22, s22, 16
    s_cmp_lg_u32 s22, 0
    s_cbranch_scc1 L_flagok
    buffer_load_dword v126, v127, s[44:47], 0 offen sc1
    s_waitcnt vmcnt(0)
    s_branch L_flagwait
L_flagok:
    v_lshrrev_b32 v40, 4, v3
    v_lshlrev_b32 v40, 4, v40
    s_lshl_b32 s22, s71, 6
    s_add_u32 s22, s22, 1024
    v_add_u32 v40, s22, v40
    s_mov_b32 exec_lo, 0x00010001
    s_mov_b32 exec_hi, 0x00010001
    buffer_store_dwordx4 v[44:47], v40, s[64:67], 0 offen sc1
    s_mov_b64 exec, -1
    v_mov_b32 v8, 0
    v_mov_b32 v9, 0
    v_mov_b32 v10, 0
    v_mov_b32 v11, 0
    v_mov_b32 v12, 0
    v_mov_b32 v13, 0
    v_mov_b32 v14, 0
    v_mov_b32 v15, 0
    v_mov_b32 v16, 0
    v_mov_b32 v17, 0
    v_mov_b32 v18, 0
    v_mov_b32 v19, 0
    v_mov_b32 v20, 0
    v_mov_b32 v21, 0
    v_mov_b32 v22, 0
    v_mov_b32 v23, 0
    v_mov_b32 v24, 0
    v_mov_b32 v25, 0
    v_mov_b32 v26, 0
    v_mov_b32 v27, 0
    v_mov_b32 v28, 0
    v_mov_b32 v29, 0
    v_mov_b32 v30, 0
    v_mov_b32 v31, 0
    v_mov_b32 v32, 0
    v_mov_b32 v33, 0
    v_mov_b32 v34, 0
    v_mov_b32 v35, 0
    v_mov_b32 v36, 0
    v_mov_b32 v37, 0
    v_mov_b32 v38, 0
    v_mov_b32 v39, 0
    s_mov_b32 s61, 1
    s_mov_b32 s75, 1
    s_branch L_flushret
L_exit:
    s_mov_b32 s74, 1
L_exitp:
    s_cmp_eq_u32 s72, 2
    s_cbranch_scc1 L_havep
    buffer_load_dwordx4 v[128:131], v132, s[64:67], 0 offen sc1
    s_waitcnt vmcnt(0)
    s_branch L_pchk_x
L_havep:
    v_mul_f32 v40, v128, v8
    v_mul_f32 v41, v128, v12
    v_mul_f32 v42, v128, v16
    v_mul_f32 v43, v128, v20
    v_mul_f32 v44, v128, v24
    v_mul_f32 v45, v128, v28
    v_mul_f32 v46, v128, v32
    v_mul_f32 v47, v128, v36
    v_fmac_f32 v40, v129, v9
    v_fmac_f32 v41, v129, v13
    v_fmac_f32 v42, v129, v17
    v_fmac_f32 v43, v129, v21
    v_fmac_f32 v44, v129, v25
    v_fmac_f32 v45, v129, v29
    v_fmac_f32 v46, v129, v33
    v_fmac_f32 v47, v129, v37
    v_fmac_f32 v40, v130, v10
    v_fmac_f32 v41, v130, v14
    v_fmac_f32 v42, v130, v18
    v_fmac_f32 v43, v130, v22
    v_fmac_f32 v44, v130, v26
    v_fmac_f32 v45, v130, v30
    v_fmac_f32 v46, v130, v34
    v_fmac_f32 v47, v130, v38
    v_fmac_f32 v40, v131, v11
    v_fmac_f32 v41, v131, v15
    v_fmac_f32 v42, v131, v19
    v_fmac_f32 v43, v131, v23
    v_fmac_f32 v44, v131, v27
    v_fmac_f32 v45, v131, v31
    v_fmac_f32 v46, v131, v35
    v_fmac_f32 v47, v131, v39
    s_nop 1
    v_permlane32_swap_b32 v40, v44
    v_permlane32_swap_b32 v41, v45
    v_permlane32_swap_b32 v42, v46
    v_permlane32_swap_b32 v43, v47
    s_nop 1
    v_add_f32 v40, v40, v44
    v_add_f32 v41, v41, v45
    v_add_f32 v42, v42, v46
    v_add_f32 v43, v43, v47
    s_nop 1
    v_permlane16_swap_b32 v40, v42
    v_permlane16_swap_b32 v41, v43
    s_nop 1
    v_add_f32 v40, v40, v42
    v_add_f32 v41, v41, v43
    v_lshlrev_b32 v48, 3, v3
    s_lshl_b32 s22, s20, 9
    v_add_u32 v49, s22, v48
    ds_write_b64 v49, v[40:41]
    s_lshl_b32 s22, s21, 9
    v_add_u32 v56, s22, v48
    v_add_u32 v56, 2048, v56
    s_add_u32 s23, s21, 1
    s_and_b32 s23, s23, 3
    s_lshl_b32 s23, s23, 9
    s_add_u32 s23, s23, 2048
    v_add_u32 v57, s23, v48
    s_add_u32 s23, s21, 2
    s_and_b32 s23, s23, 3
    s_lshl_b32 s23, s23, 9
    s_add_u32 s23, s23, 2048
    v_add_u32 v58, s23, v48
    s_add_u32 s23, s21, 3
    s_and_b32 s23, s23, 3
    s_lshl_b32 s23, s23, 9
    s_add_u32 s23, s23, 2048
    v_add_u32 v59, s23, v48
    v_mov_b32 v60, 1
    v_mov_b32 v61, 128
    s_waitcnt lgkmcnt(0)
    s_barrier
    s_cmp_lg_u32 s20, 0
    s_cbranch_scc1 L_done
    s_mov_b64 exec, 1
    buffer_atomic_add v60, v61, s[64:67], 0 offen sc0
    s_mov_b64 exec, -1
    buffer_load_dwordx2 v[64:65], v57, s[64:67], 0 offen sc1
    buffer_load_dwordx2 v[66:67], v58, s[64:67], 0 offen sc1
    buffer_load_dwordx2 v[68:69], v59, s[64:67], 0 offen sc1
    ds_read_b64 v[50:51], v48 offset:512
    ds_read_b64 v[52:53], v48 offset:1024
    ds_read_b64 v[54:55], v48 offset:1536
    s_mov_b32 s22, 0xfffffffe
    s_waitcnt lgkmcnt(0)
    v_add_f32 v40, v40, v50
    v_add_f32 v41, v41, v51
    v_add_f32 v52, v52, v54
    v_add_f32 v53, v53, v55
    v_add_f32 v40, v40, v52
    v_add_f32 v41, v41, v53
    v_min_u32 v62, s22, v40
    v_min_u32 v63, s22, v41
    buffer_store_dwordx2 v[62:63], v56, s[64:67], 0 offen sc1
    s_waitcnt vmcnt(1)
    v_readfirstlane_b32 s22, v60
    s_cmp_lg_u32 s22, 3
    s_cbranch_scc1 L_done
L_chk:
    v_max_u32 v70, v64, v65
    v_max3_u32 v70, v66, v67, v70
    v_max3_u32 v70, v68, v69, v70
    v_cmp_eq_u32 vcc, -1, v70
    s_nop 4
    s_cbranch_vccz L_ok
    buffer_load_dwordx2 v[64:65], v57, s[64:67], 0 offen sc1
    buffer_load_dwordx2 v[66:67], v58, s[64:67], 0 offen sc1
    buffer_load_dwordx2 v[68:69], v59, s[64:67], 0 offen sc1
    s_waitcnt vmcnt(0)
    s_branch L_chk
L_ok:
    v_add_f32 v40, v40, v66
    v_add_f32 v41, v41, v67
    v_add_f32 v64, v64, v68
    v_add_f32 v65, v65, v69
    v_add_f32 v40, v40, v64
    v_add_f32 v41, v41, v65
    v_cvt_pk_bf16_f32 v40, v40, v41
    v_and_b32 v71, 15, v3
    v_lshlrev_b32 v71, 4, v71
    v_lshrrev_b32 v72, 4, v3
    v_lshl_add_u32 v71, v72, 2, v71
    buffer_store_dword v40, v71, s[40:43], 0 offen
L_done:
L_end:
    s_endpgm
.section .rodata,"a"
.p2align 6
.amdhsa_kernel standalone__low_rank_proj_linformer__decode_kernel
  .amdhsa_next_free_vgpr 144
  .amdhsa_next_free_sgpr 100
  .amdhsa_accum_offset 144
  .amdhsa_group_segment_fixed_size 0
  .amdhsa_kernarg_size 64
  .amdhsa_user_sgpr_count 2
  .amdhsa_user_sgpr_kernarg_segment_ptr 1
  .amdhsa_system_sgpr_workgroup_id_x 1
.end_amdhsa_kernel
```
